```python
import torch

def _softmax(x, axis=-1):
    return torch.softmax(x, dim=axis)
def _gelu(x):
    return torch.nn.functional.gelu(x, approximate="tanh")
def _silu(x):
    return torch.nn.functional.silu(x)
def _sigmoid(x):
    return torch.sigmoid(x)
def _layernorm(x, axis=-1, eps=1e-5):
    m = x.mean(dim=axis, keepdim=True)
    v = x.var(dim=axis, keepdim=True, unbiased=False)
    return (x - m) / torch.sqrt(v + eps)
def _scatter_add(tgt, idx, src, axis=0):
    return tgt.clone().index_add_(axis, idx, src)
def _segment_sum(src, seg, n):
    out = torch.zeros((n,) + src.shape[1:], dtype=src.dtype)
    return out.index_add_(0, seg, src)
def _pad(x, pw):
    flat = tuple(v for pair in reversed(pw) for v in pair)
    return torch.nn.functional.pad(x, flat)

kernel_name = 'parallel_sum__compressed_kv_cla__glu_gated_glu__decode'

def setup_inputs():

    _w = (lambda a: (lambda t: t.to(torch.bfloat16) if t.is_floating_point() else t)(torch.as_tensor(a)))
    def _A_setup():
        B, H, Sq, Sk, D, M = 2, 32, 1, 4096, 128, 512
        Dc = 4 * D
        return {
            "x": _w((lambda *s: torch.randn(*s, dtype=torch.bfloat16) * 0.05)(B, Sq, M)),
            "c_kv": _w((lambda *s: torch.randn(*s, dtype=torch.bfloat16) * 1.6)(B, Sk, Dc)),
            "w_q": _w((lambda *s: torch.randn(*s, dtype=torch.bfloat16) * 1.6)(M, H, D) * (M ** -0.5)),
            "w_uk": _w((lambda *s: torch.randn(*s, dtype=torch.bfloat16) * 1.6)(Dc, H, D) * (Dc ** -0.5)),
            "w_uv": _w((lambda *s: torch.randn(*s, dtype=torch.bfloat16) * 1.6)(Dc, H, D) * (Dc ** -0.5)),
            "w_o": _w((lambda *s: torch.randn(*s, dtype=torch.bfloat16) * 1.6)(H, D, M) * ((H * D) ** -0.5)),
        }
    _A_in = _A_setup()

    def _B_setup():
        B, S, D, F = 2, 1, 512, 1376
        return {
            "x": _w((lambda *s: torch.randn(*s, dtype=torch.bfloat16) * 0.05)(B, S, D)),
            "w_gate": _w((lambda *s: torch.randn(*s, dtype=torch.bfloat16) * 0.1)(D, F)),
            "w_up": _w((lambda *s: torch.randn(*s, dtype=torch.bfloat16) * 0.05)(D, F)),
            "w_down": _w((lambda *s: torch.randn(*s, dtype=torch.bfloat16) * 0.05)(F, D)),
        }
    _B_in = _B_setup()

    return {
        "A_x": _A_in["x"],
        "A_c_kv": _A_in["c_kv"],
        "A_w_q": _A_in["w_q"],
        "A_w_uk": _A_in["w_uk"],
        "A_w_uv": _A_in["w_uv"],
        "A_w_o": _A_in["w_o"],
        "B_x": _B_in["x"],
        "B_w_gate": _B_in["w_gate"],
        "B_w_up": _B_in["w_up"],
        "B_w_down": _B_in["w_down"],
    }

def reference(A_x, A_c_kv, A_w_q, A_w_uk, A_w_uv, A_w_o, B_x, B_w_gate, B_w_up, B_w_down):
    def _A_ref(x, c_kv, w_q, w_uk, w_uv, w_o):
        B, Sq, M = x.shape[0], x.shape[1], x.shape[2]
        Sk = c_kv.shape[1]
        H, D = w_q.shape[1], w_q.shape[2]
        q = torch.einsum("bqm,mhd->bhqd", x, w_q)
        k = torch.einsum("bkc,chd->bhkd", c_kv, w_uk)
        v = torch.einsum("bkc,chd->bhkd", c_kv, w_uv)
        scores = torch.einsum("bhqd,bhkd->bhqk", q, k) * (D ** -0.5)
        off = Sk - Sq
        qi = torch.arange(Sq)[:, None]
        kj = torch.arange(Sk)[None, :]
        cmask = kj <= (qi + off)
        scores = torch.where(cmask[None, None], scores, -1e9)
        p = _softmax(scores, axis=-1)
        ctx = torch.einsum("bhqk,bhkd->bhqd", p, v)
        return torch.einsum("bhqd,hdm->bqm", ctx, w_o)

    def _B_ref(x, w_gate, w_up, w_down):
        g = torch.einsum("bsd,df->bsf", x, w_gate)
        u = torch.einsum("bsd,df->bsf", x, w_up)
        h = _sigmoid(g) * u
        return torch.einsum("bsf,fd->bsd", h, w_down)

    x = A_x
    xn = _layernorm(x, axis=-1)
    return x + _A_ref(xn, A_c_kv, A_w_q, A_w_uk, A_w_uv, A_w_o) + _B_ref(xn, B_w_gate, B_w_up, B_w_down)
```

```asm
; @launch grid=(256,1,1) block=(512,1,1) lds=163264
.amdgcn_target "amdgcn-amd-amdhsa--gfx950"
.text
.globl parallel_sum__compressed_kv_cla__glu_gated_glu__decode_kernel
.p2align 12
.p2align 8
.type parallel_sum__compressed_kv_cla__glu_gated_glu__decode_kernel,@function
parallel_sum__compressed_kv_cla__glu_gated_glu__decode_kernel:
    s_load_dwordx2 s[12:13], s[0:1], 16
    s_load_dwordx2 s[4:5], s[0:1], 0
    s_load_dwordx2 s[16:17], s[0:1], 24
    s_load_dwordx2 s[8:9], s[0:1], 8
    s_load_dwordx2 s[44:45], s[0:1], 96
    s_cmp_ge_u32 s2, 256
    s_cbranch_scc1 L_END
    v_lshrrev_b32 v9, 6, v0
    v_and_b32 v1, 63, v0
    v_readfirstlane_b32 s3, v9
    v_and_b32 v2, 15, v0
    v_bfe_u32 v3, v0, 4, 2
    s_and_b32 s68, s2, 7
    s_bfe_u32 s78, s2, 0x30003
    s_lshr_b32 s70, s2, 6
    s_lshl2_add_u32 s79, s68, s70
    s_mov_b32 s14, 0x400000
    s_mov_b32 s15, 0x20000
    s_mov_b32 s6, 0x800
    s_mov_b32 s7, 0x20000
    s_mov_b32 s18, 0x400000
    s_mov_b32 s19, 0x20000
    s_mov_b32 s46, 0x10000000
    s_mov_b32 s47, 0x20000
    v_and_b32 v9, 1, v3
    v_lshlrev_b32 v8, 15, v9
    v_lshrrev_b32 v10, 1, v3
    v_lshl_add_u32 v8, v10, 18, v8
    v_lshl_add_u32 v8, v2, 4, v8
    s_lshl_b32 s86, s78, 19
    s_lshl_b32 s85, s79, 8
    s_add_u32 s86, s86, s85
    s_lshr_b32 s83, s3, 1
    s_and_b32 s84, s3, 1
    s_lshl2_add_u32 s93, s83, s84
    s_lshl_b32 s83, s93, 14
    s_add_u32 s92, s86, s83
    s_add_u32 s85, s92, 8192
    s_mul_i32 s94, s3, 2112
    s_add_u32 m0, s94, 146368
    v_lshlrev_b32 v4, 4, v1
    v_lshlrev_b32 v5, 4, v3
    v_and_b32 v23, 1, v2
    v_lshl_add_u32 v11, v23, 10, v5
    v_lshrrev_b32 v10, 1, v2
    v_lshl_add_u32 v11, v10, 7, v11
    s_lshl3_add_u32 s81, s79, s78
    s_lshl3_add_u32 s83, s81, s3
    s_lshl_b32 s83, s83, 7
    s_add_u32 s77, s83, 0x110000
    s_lshl_b32 s87, s84, 10
    s_add_u32 s87, s87, 4608
    s_lshl_b32 s84, s84, 6
    s_waitcnt lgkmcnt(0)
    s_load_dword s48, s[44:45], 0
    buffer_load_dwordx4 v8, s[12:15], s92 offen lds
    s_add_u32 m0, m0, 1056
    s_cmp_lt_u32 s3, 2
    buffer_load_dwordx4 v8, s[12:15], s85 offen lds
    s_cbranch_scc0 L_nox
    s_mov_b32 m0, s87
    s_nop 0
    buffer_load_dwordx4 v11, s[4:7], s84 offen lds
L_nox:
    s_barrier
    s_add_u32 s89, s83, 0x70000
    v_mul_u32_u24 v9, 0xa0000, v1
    s_mov_b64 exec, 3
    buffer_load_dword v38, v9, s[44:47], s89 offen sc1
    s_mov_b64 exec, -1
    s_add_u32 s85, s83, 0x10000
    s_lshl3_add_u32 s84, s2, s3
    s_lshl_b32 s84, s84, 9
    s_add_u32 s84, s84, 0xf0000
    s_cmp_lt_u32 s2, 32
    s_cselect_b32 s84, s84, 0x7f000000
    v_lshlrev_b32 v9, 7, v1
    s_mov_b64 exec, 15
    buffer_load_dword v39, v9, s[44:47], s84 offen sc1
    s_mov_b64 exec, -1
    s_mov_b32 s10, 0x800000
    s_mov_b32 s11, 0x20000
    s_lshr_b32 s69, s2, 3
    s_lshr_b32 s83, s69, 2
    s_lshl3_add_u32 s72, s68, s83
    s_and_b32 s82, s3, 3
    s_mul_i32 s74, s82, 16896
    s_add_u32 s74, s74, 28096
    s_and_b32 s83, s69, 2
    s_lshl3_add_u32 s83, s83, s82
    s_lshl_b32 s83, s83, 12
    s_lshl_b32 s73, s72, 17
    s_add_u32 s73, s73, s83
    s_bitcmp1_b32 s2, 3
    s_cbranch_scc0 L_fetch0
    s_add_u32 m0, s94, 44992
    s_add_u32 s83, s92, 8192
    buffer_load_dwordx4 v8, s[16:19], s92 offen lds
    s_add_u32 m0, m0, 1056
    s_nop 0
    buffer_load_dwordx4 v8, s[16:19], s83 offen lds
    s_add_u32 m0, s94, 28096
    s_sub_u32 s83, s92, 0x80000
    buffer_load_dwordx4 v8, s[16:19], s83 offen lds
    s_add_u32 m0, m0, 1056
    s_add_u32 s83, s83, 8192
    buffer_load_dwordx4 v8, s[16:19], s83 offen lds
    s_branch L_r0
L_fetch0:
    s_cmp_lt_u32 s3, 4
    s_cbranch_scc1 L_r0
    s_add_u32 m0, s74, 0
    s_nop 0
    buffer_load_dwordx4 v4, s[8:11], s73 offen offset:0 lds
    s_add_u32 m0, s74, 32
    s_nop 0
    buffer_load_dwordx4 v4, s[8:11], s73 offen offset:1024 lds
L_r0:
    s_load_dwordx2 s[20:21], s[0:1], 32
    s_load_dwordx2 s[24:25], s[0:1], 40
    s_load_dwordx2 s[28:29], s[0:1], 56
    s_load_dwordx2 s[32:33], s[0:1], 64
    s_load_dwordx2 s[36:37], s[0:1], 72
    s_load_dwordx2 s[40:41], s[0:1], 80
    s_mov_b32 s22, 0x400000
    s_mov_b32 s23, 0x20000
    s_mov_b32 s26, 0x400000
    s_mov_b32 s27, 0x20000
    s_mov_b32 s30, 0x158000
    s_mov_b32 s31, 0x20000
    s_mov_b32 s34, 0x158000
    s_mov_b32 s35, 0x20000
    s_mov_b32 s38, 0x158000
    s_mov_b32 s39, 0x20000
    s_mov_b32 s42, 0x800
    s_mov_b32 s43, 0x20000
    s_and_b32 s71, s69, 3
    s_lshl3_add_u32 s80, s70, s68
    s_mov_b32 s54, 0x00ff00ff
    s_mov_b32 s55, 0x00ff00ff
    s_mov_b32 s52, 0x00030003
    s_mov_b32 s53, 0x00030003
    s_lshl_b32 s83, s78, 1
    s_lshl_b64 s[64:65], s[52:53], s83
    s_getreg_b32 s67, hwreg(HW_REG_XCC_ID)
    s_mov_b32 s88, 0x3f803f80
    v_mov_b32 v124, s88
    v_mov_b32 v125, s88
    v_mov_b32 v126, s88
    v_mov_b32 v127, s88
    v_cmp_lt_u32 s[62:63], 7, v2
    v_lshrrev_b32 v9, 2, v1
    v_and_b32 v10, 3, v1
    v_and_b32 v11, 1, v9
    v_mul_u32_u24 v7, 1056, v9
    v_lshl_add_u32 v7, v10, 3, v7
    s_lshl_b32 s83, s3, 5
    v_add_u32 v12, s83, v7
    v_add_u32 v22, 146368, v12
    v_lshl_add_u32 v13, v23, 6, v5
    v_lshrrev_b32 v112, 3, v1
    v_bfe_u32 v113, v1, 3, 1
    v_lshrrev_b32 v115, 5, v1
    v_and_b32 v6, 7, v1
    v_lshlrev_b32 v117, 4, v6
    v_mul_u32_u24 v114, 1056, v2
    v_add_u32 v114, v114, v5
    v_and_b32 v116, 1, v3
    v_mul_u32_u24 v31, 288, v11
    v_lshl_add_u32 v31, v10, 3, v31
    v_lshl_add_u32 v31, v112, 5, v31
    s_mul_i32 s83, s3, 576
    v_add_u32 v31, s83, v31
    v_mul_u32_u24 v32, 288, v2
    v_add_u32 v32, v32, v5
    s_and_b32 s83, s3, 1
    s_lshl_b32 s83, s83, 9
    s_lshr_b32 s84, s82, 1
    s_mul_i32 s84, s84, 16896
    s_add_u32 s83, s83, s84
    v_add_u32 v24, s83, v114
    v_lshl_add_u32 v25, v3, 1, v113
    v_lshlrev_b32 v25, 4, v25
    v_lshl_add_u32 v25, v23, 16, v25
    s_lshl3_add_u32 s83, s79, s3
    s_lshl_b32 s90, s83, 10
    v_mov_b32 v60, 0
    v_mov_b32 v62, 0
    v_mov_b32 v63, 1
    s_mov_b64 exec, 1
    ds_write_b64 v60, v[62:63] offset:11136
    s_mov_b64 exec, -1
    s_waitcnt lgkmcnt(0)
    s_add_u32 s48, s48, 1
    s_not_b32 s49, s48
    v_mov_b32 v48, s48
    v_mov_b32 v49, s49
    s_and_b32 s67, s67, 15
    s_add_u32 s67, s67, 1
    s_xor_b32 s67, s67, s49
    s_mov_b32 s66, s48
    v_mov_b32 v64, s48
    v_mov_b32 v65, s67
    s_bitcmp1_b32 s2, 3
    s_cbranch_scc0 L_wr_2
    s_waitcnt vmcnt(6)
    s_branch L_wr_1
L_wr_2:
    s_waitcnt vmcnt(4)
    s_cmp_ge_u32 s3, 4
    s_cbranch_scc1 L_wr_1
    s_waitcnt vmcnt(2)
L_wr_1:
    s_barrier
    ds_read_b128 v[40:43], v4 offset:4608
    ds_read_b128 v[44:47], v4 offset:5632
    ds_read_b64_tr_b16 v[80:81], v22 offset:0
    ds_read_b64_tr_b16 v[82:83], v22 offset:256
    ds_read_b64_tr_b16 v[84:85], v22 offset:512
    ds_read_b64_tr_b16 v[86:87], v22 offset:768
    s_waitcnt lgkmcnt(4)
    v_mfma_f32_16x16x32_bf16 v[60:63], v[124:127], v[40:43], 0
    v_mfma_f32_16x16x32_bf16 v[60:63], v[124:127], v[44:47], v[60:63]
    s_waitcnt lgkmcnt(2)
    v_mfma_f32_16x16x32_bf16 v[52:55], v[80:83], v[40:43], 0
    v_mfma_f32_16x16x32_bf16 v[56:59], v[80:83], v[124:127], 0
    s_waitcnt lgkmcnt(0)
    v_mfma_f32_16x16x32_bf16 v[52:55], v[84:87], v[44:47], v[52:55]
    v_mfma_f32_16x16x32_bf16 v[56:59], v[84:87], v[124:127], v[56:59]
    s_barrier
    s_nop 0
    v_add_f32_dpp v60, v60, v60 row_ror:8 row_mask:0xf bank_mask:0xf
    s_nop 1
    v_add_f32_dpp v60, v60, v60 row_ror:4 row_mask:0xf bank_mask:0xf
    s_nop 1
    v_add_f32_dpp v60, v60, v60 row_ror:2 row_mask:0xf bank_mask:0xf
    v_mul_f32 v36, 0xbb000000, v60
    v_fmac_f32 v52, v56, v36
    v_fmac_f32 v53, v57, v36
    v_fmac_f32 v54, v58, v36
    v_fmac_f32 v55, v59, v36
    s_mov_b64 exec, s[64:65]
    v_cvt_pk_bf16_f32 v66, v52, v53
    v_cvt_pk_bf16_f32 v67, v54, v55
    buffer_store_dwordx4 v[64:67], v13, s[44:47], s77 offen
    v_cvt_pk_bf16_f32 v50, v52, v53
    v_cvt_pk_bf16_f32 v51, v54, v55
    buffer_store_dwordx4 v[48:51], v13, s[44:47], s85 offen sc1
    s_mov_b64 exec, -1
    s_bitcmp1_b32 s2, 3
    s_cbranch_scc1 L_nof1
    s_cmp_lt_u32 s3, 4
    s_cbranch_scc1 L_nof1
    s_add_u32 m0, s74, 64
    s_nop 0
    buffer_load_dwordx4 v4, s[8:11], s73 offen offset:2048 lds
    s_add_u32 m0, s74, 96
    s_nop 0
    buffer_load_dwordx4 v4, s[8:11], s73 offen offset:3072 lds
    s_add_u32 s73, s73, 0x4000
    s_add_u32 m0, s74, 4224
    s_nop 0
    buffer_load_dwordx4 v4, s[8:11], s73 offen offset:0 lds
    s_add_u32 m0, s74, 4256
    s_nop 0
    buffer_load_dwordx4 v4, s[8:11], s73 offen offset:1024 lds
    s_add_u32 m0, s74, 4288
    s_nop 0
    buffer_load_dwordx4 v4, s[8:11], s73 offen offset:2048 lds
    s_add_u32 m0, s74, 4320
    s_nop 0
    buffer_load_dwordx4 v4, s[8:11], s73 offen offset:3072 lds
    s_add_u32 s73, s73, 0x4000
    s_add_u32 m0, s74, 8448
    s_nop 0
    buffer_load_dwordx4 v4, s[8:11], s73 offen offset:0 lds
    s_add_u32 m0, s74, 8480
    s_nop 0
    buffer_load_dwordx4 v4, s[8:11], s73 offen offset:1024 lds
    s_add_u32 m0, s74, 8512
    s_nop 0
    buffer_load_dwordx4 v4, s[8:11], s73 offen offset:2048 lds
    s_add_u32 m0, s74, 8544
    s_nop 0
    buffer_load_dwordx4 v4, s[8:11], s73 offen offset:3072 lds
L_nof1:
    v_dot2_f32_bf16 v68, v40, v40, 0
    v_dot2_f32_bf16 v68, v41, v41, v68
    v_dot2_f32_bf16 v68, v42, v42, v68
    v_dot2_f32_bf16 v68, v43, v43, v68
    v_dot2_f32_bf16 v68, v44, v44, v68
    v_dot2_f32_bf16 v68, v45, v45, v68
    v_dot2_f32_bf16 v68, v46, v46, v68
    v_dot2_f32_bf16 v68, v47, v47, v68
    s_add_u32 s84, s90, 0x110000
    s_add_u32 s85, s90, 0x10000
    s_add_u32 s90, s90, 0x70000
    v_add_f32_dpp v68, v68, v68 row_ror:8 row_mask:0xf bank_mask:0xf
    s_nop 1
    v_add_f32_dpp v68, v68, v68 row_ror:4 row_mask:0xf bank_mask:0xf
    s_nop 1
    v_add_f32_dpp v68, v68, v68 row_ror:2 row_mask:0xf bank_mask:0xf
    v_mov_b32 v69, v68
    s_nop 1
    v_permlane16_swap_b32 v68, v69
    v_add_f32 v68, v68, v69
    v_mov_b32 v69, v68
    s_nop 1
    v_permlane32_swap_b32 v68, v69
    v_add_f32 v68, v68, v69
    v_mul_f32 v68, 0x3b000000, v68
    v_fma_f32 v68, -v36, v36, v68
    v_max_f32 v68, 0, v68
    v_add_f32 v68, 0x3727c5ac, v68
    v_rsq_f32 v37, v68
    s_lshr_b32 s83, s82, 1
    v_mul_f32 v34, 0x3e0293ee, v37
    v_readlane_b32 s76, v37, s83
    s_bitcmp1_b32 s2, 3
    s_cbranch_scc0 L_pc2
    s_waitcnt vmcnt(2)
    buffer_load_dwordx4 v[56:59], v4, s[44:47], s84 offen sc1
    s_waitcnt vmcnt(3)
    s_barrier
    s_cmp_ge_u32 s3, 4
    s_cbranch_scc1 L_nowu
    ds_read_b128 v[128:131], v24 offset:28096
    ds_read_b128 v[132:135], v24 offset:28160
    ds_read_b128 v[136:139], v24 offset:28224
    ds_read_b128 v[140:143], v24 offset:28288
    ds_read_b128 v[144:147], v24 offset:28352
    ds_read_b128 v[148:151], v24 offset:28416
    ds_read_b128 v[152:155], v24 offset:28480
    ds_read_b128 v[156:159], v24 offset:28544
L_nowu:
    s_waitcnt vmcnt(0)
    v_cmp_ne_u64 vcc, s[66:67], v[56:57]
    s_cmp_lg_u64 vcc, 0
    s_cbranch_scc0 L_h0_done
    s_mov_b32 s87, 0
L_h0_retry:
    s_add_u32 s87, s87, 1
    s_cmp_gt_u32 s87, 20000
    s_cbranch_scc1 L_END
    buffer_load_dwordx4 v[56:59], v4, s[44:47], s84 offen sc1
    s_waitcnt vmcnt(0)
    v_cmp_ne_u64 vcc, s[66:67], v[56:57]
    s_cmp_lg_u64 vcc, 0
    s_cbranch_scc0 L_h0_done
    s_cmp_lt_u32 s87, 6
    s_cbranch_scc1 L_h0_retry
    buffer_load_dwordx4 v[56:59], v4, s[44:47], s85 offen sc1
    s_waitcnt vmcnt(0)
    v_cmp_ne_u64 vcc, s[48:49], v[56:57]
    s_cmp_lg_u64 vcc, 0
    s_cbranch_scc1 L_h0_retry
L_h0_done:
    ds_write_b64 v31, v[58:59] offset:0
    s_waitcnt lgkmcnt(0)
    s_barrier
    s_cmp_ge_u32 s3, 4
    s_cbranch_scc1 L_a1_hi
    ds_read_b128 v[160:163], v32 offset:0
    ds_read_b128 v[164:167], v32 offset:64
    ds_read_b128 v[168:171], v32 offset:128
    ds_read_b128 v[172:175], v32 offset:192
    s_lshl1_add_u32 s83, s81, s3
    s_lshl_b32 s83, s83, 7
    s_add_u32 s83, s83, 0x4ff00
    s_waitcnt lgkmcnt(3)
    v_mfma_f32_16x16x32_bf16 v[56:59], v[128:131], v[160:163], 0
    v_mfma_f32_16x16x32_bf16 v[60:63], v[144:147], v[160:163], 0
    s_waitcnt lgkmcnt(2)
    v_mfma_f32_16x16x32_bf16 v[56:59], v[132:135], v[164:167], v[56:59]
    v_mfma_f32_16x16x32_bf16 v[60:63], v[148:151], v[164:167], v[60:63]
    s_waitcnt lgkmcnt(1)
    v_mfma_f32_16x16x32_bf16 v[56:59], v[136:139], v[168:171], v[56:59]
    v_mfma_f32_16x16x32_bf16 v[60:63], v[152:155], v[168:171], v[60:63]
    s_waitcnt lgkmcnt(0)
    v_mfma_f32_16x16x32_bf16 v[56:59], v[140:143], v[172:175], v[56:59]
    v_mfma_f32_16x16x32_bf16 v[60:63], v[156:159], v[172:175], v[60:63]
    s_nop 6
    v_add_f32_dpp v52, v56, v56 row_ror:8 row_mask:0xf bank_mask:0x3
    v_add_f32_dpp v53, v57, v57 row_ror:8 row_mask:0xf bank_mask:0x3
    v_add_f32_dpp v54, v58, v58 row_ror:8 row_mask:0xf bank_mask:0x3
    v_add_f32_dpp v55, v59, v59 row_ror:8 row_mask:0xf bank_mask:0x3
    v_add_f32_dpp v52, v60, v60 row_ror:8 row_mask:0xf bank_mask:0xc
    v_add_f32_dpp v53, v61, v61 row_ror:8 row_mask:0xf bank_mask:0xc
    v_add_f32_dpp v54, v62, v62 row_ror:8 row_mask:0xf bank_mask:0xc
    v_add_f32_dpp v55, v63, v63 row_ror:8 row_mask:0xf bank_mask:0xc
    v_add_f32_dpp v52, v52, v52 row_shl:4 row_mask:0xf bank_mask:0x5
    v_add_f32_dpp v53, v53, v53 row_shl:4 row_mask:0xf bank_mask:0x5
    v_add_f32_dpp v54, v54, v54 row_shl:4 row_mask:0xf bank_mask:0x5
    v_add_f32_dpp v55, v55, v55 row_shl:4 row_mask:0xf bank_mask:0x5
    v_add_f32_dpp v52, v52, v52 quad_perm:[2,3,0,1] row_mask:0xf bank_mask:0xf
    v_add_f32_dpp v53, v53, v53 quad_perm:[2,3,0,1] row_mask:0xf bank_mask:0xf
    v_add_f32_dpp v54, v54, v54 quad_perm:[2,3,0,1] row_mask:0xf bank_mask:0xf
    v_add_f32_dpp v55, v55, v55 quad_perm:[2,3,0,1] row_mask:0xf bank_mask:0xf
    v_mul_f32 v52, v34, v52
    v_mul_f32 v53, v34, v53
    v_mul_f32 v54, v34, v54
    v_mul_f32 v55, v34, v55
    v_cvt_pk_bf16_f32 v50, v52, v53
    v_cvt_pk_bf16_f32 v51, v54, v55
    s_mov_b32 exec_lo, 0x03030303
    s_mov_b32 exec_hi, 0x03030303
    buffer_store_dwordx4 v[48:51], v25, s[44:47], s83 offen sc1
    s_mov_b64 exec, -1
    s_branch L_pc2
L_a1_hi:
    s_add_u32 m0, s74, 0
    s_nop 0
    buffer_load_dwordx4 v4, s[8:11], s73 offen offset:0 lds
    s_add_u32 m0, s74, 32
    s_nop 0
    buffer_load_dwordx4 v4, s[8:11], s73 offen offset:1024 lds
    s_add_u32 m0, s74, 64
    s_nop 0
    buffer_load_dwordx4 v4, s[8:11], s73 offen offset:2048 lds
    s_add_u32 m0, s74, 96
    s_nop 0
    buffer_load_dwordx4 v4, s[8:11], s73 offen offset:3072 lds
    s_add_u32 s73, s73, 0x4000
    s_add_u32 m0, s74, 4224
    s_nop 0
    buffer_load_dwordx4 v4, s[8:11], s73 offen offset:0 lds
    s_add_u32 m0, s74, 4256
    s_nop 0
    buffer_load_dwordx4 v4, s[8:11], s73 offen offset:1024 lds
    s_add_u32 m0, s74, 4288
    s_nop 0
    buffer_load_dwordx4 v4, s[8:11], s73 offen offset:2048 lds
    s_add_u32 m0, s74, 4320
    s_nop 0
    buffer_load_dwordx4 v4, s[8:11], s73 offen offset:3072 lds
    s_add_u32 s73, s73, 0x4000
    s_add_u32 m0, s74, 8448
    s_nop 0
    buffer_load_dwordx4 v4, s[8:11], s73 offen offset:0 lds
    s_add_u32 m0, s74, 8480
    s_nop 0
    buffer_load_dwordx4 v4, s[8:11], s73 offen offset:1024 lds
    s_add_u32 m0, s74, 8512
    s_nop 0
    buffer_load_dwordx4 v4, s[8:11], s73 offen offset:2048 lds
    s_add_u32 m0, s74, 8544
    s_nop 0
    buffer_load_dwordx4 v4, s[8:11], s73 offen offset:3072 lds
L_pc2:
    v_lshlrev_b32 v20, 5, v3
    v_lshl_add_u32 v20, v113, 2, v20
    v_lshl_add_u32 v20, v20, 10, v117
    s_lshl_b32 s85, s93, 11
    s_lshl_b32 s84, s78, 7
    s_add_u32 s85, s85, s84
    s_lshl_b32 s83, s79, 17
    s_add_u32 s83, s83, s85
    v_add_u32 v20, s83, v20
    v_lshlrev_b32 v118, 5, v116
    v_lshl_add_u32 v118, v113, 2, v118
    v_add_u32 v118, v118, v115
    v_lshl_add_u32 v21, v118, 10, v117
    s_lshl_b32 s83, s80, 16
    s_add_u32 s83, s83, s85
    v_add_u32 v21, s83, v21
    s_lshl3_add_u32 s83, s71, s82
    s_lshl_b32 s83, s83, 11
    s_lshr_b32 s84, s72, 5
    s_lshl_b32 s84, s84, 16
    s_add_u32 s83, s83, s84
    s_add_u32 s83, s83, 0x50000
    v_add_u32 v14, s83, v4
    s_mul_i32 s83, s82, 544
    v_lshl_add_u32 v15, v1, 3, s83
    s_lshl3_add_u32 s83, s81, s3
    s_lshl_b32 s83, s83, 10
    s_add_u32 s83, s83, 0x200000
    v_add_u32 v16, s83, v4
    v_lshlrev_b32 v17, 6, v116
    v_lshl_add_u32 v17, v6, 3, v17
    v_lshl_add_u32 v17, v115, 2, v17
    s_lshr_b32 s83, s3, 2
    s_lshl1_add_u32 s83, s82, s83
    s_mul_i32 s83, s83, 160
    v_add_u32 v17, s83, v17
    v_mul_u32_u24 v19, 160, v6
    v_add_u32 v18, v19, v5
    s_mul_i32 s95, s82, 2112
    s_cmp_ge_u32 s3, 4
    s_cbranch_scc1 L_pc_hi
    s_mul_i32 s95, s82, 2112
    s_lshl_b32 s84, s3, 7
    s_lshl3_add_u32 s83, s80, s78
    s_lshl_b32 s83, s83, 10
    s_add_u32 s83, s83, s84
    s_add_u32 s77, s83, 0xb0000
    s_lshl2_add_u32 s83, s78, s3
    s_lshl_b32 s83, s83, 12
    s_lshl_b32 s84, s79, 7
    s_add_u32 s83, s83, s84
    s_add_u32 s91, s83, 0xf0000
    v_mul_u32_u24 v120, 2752, v118
    v_add_u32 v120, v120, v117
    s_lshl3_add_u32 s83, s78, s82
    s_mul_i32 s75, s83, 22016
    s_lshl_b32 s84, s80, 7
    s_add_u32 s75, s75, s84
    s_cmp_lt_u32 s80, 22
    s_cselect_b32 s75, s75, 0x7f000000
    s_mul_i32 s83, s3, 16896
    s_add_u32 s83, s83, 28096
    v_add_u32 v22, s83, v114
    v_add_u32 v23, 67584, v22
    v_mul_u32_u24 v24, 544, v2
    v_add_u32 v24, v24, v5
    v_mov_b32 v26, v117
    s_lshl_b32 s83, s3, 2
    v_add_u32 v25, s83, v26
    v_mul_u32_u24 v27, 288, v6
    v_add_u32 v27, v27, v5
    v_lshl_add_u32 v27, v113, 3, v27
    s_lshl_b32 s83, s3, 6
    v_add_u32 v27, s83, v27
    v_mul_u32_u24 v30, 1056, v112
    v_lshl_add_u32 v30, v11, 9, v30
    v_lshl_add_u32 v30, v10, 3, v30
    s_lshl_b32 s83, s82, 5
    s_add_u32 s83, s83, 11200
    v_add_u32 v30, s83, v30
    v_lshl_add_u32 v28, v10, 2, v3
    v_lshl_add_u32 v28, v11, 9, v28
    s_lshl_b32 s83, s2, 4
    v_add_lshl_u32 v28, v28, s83, 1
    v_mul_u32_u24 v29, 160, v2
    v_add_u32 v29, v29, v5
    s_mov_b64 exec, 0
    s_cmp_eq_u32 s3, 0
    s_cbranch_scc1 L_stub_0
    s_cmp_eq_u32 s3, 1
    s_cbranch_scc1 L_stub_1
    s_cmp_eq_u32 s3, 2
    s_cbranch_scc1 L_stub_2
    s_branch L_stub_3
L_back:
    s_mov_b64 exec, -1
    s_cmp_lg_u32 s3, 0
    s_cbranch_scc1 L_pc_end
    v_lshlrev_b32 v72, 10, v1
    s_add_u32 s84, s90, 0xa0000
    s_mov_b32 s87, 0
    s_mov_b64 exec, 0xff
L_loc:
    buffer_load_dwordx2 v[74:75], v72, s[44:47], s84 offen sc1
    s_add_u32 s87, s87, 1
    s_waitcnt vmcnt(0)
    v_cmp_ne_u64 vcc, s[66:67], v[74:75]
    s_cbranch_vccz L_locok
    s_cmp_lt_u32 s87, 3
    s_cbranch_scc1 L_loc
    v_mov_b32 v72, 0
    ds_write_b32 v72, v72 offset:11140
L_locok:
    s_mov_b64 exec, -1
    s_branch L_pc_end
L_pc_hi:
    s_lshl_b32 s83, s82, 8
    s_add_u32 s83, s83, 28096
    v_add_u32 v22, s83, v7
    v_add_u32 v23, 67584, v22
    v_mul_u32_u24 v24, 288, v6
    v_add_u32 v24, v24, v5
    v_mov_b32 v26, v117
    v_lshl_add_u32 v25, v113, 6, v5
    v_lshl_add_u32 v25, v6, 16, v25
    s_lshl_b32 s83, s71, 19
    s_lshl_b32 s84, s82, 14
    s_add_u32 s83, s83, s84
    s_lshl_b32 s84, s72, 7
    s_add_u32 s83, s83, s84
    s_add_u32 s83, s83, 0x200000
    v_add_u32 v25, s83, v25
    s_lshl_b32 s83, s82, 16
    s_add_u32 s92, s86, s83
    v_lshlrev_b32 v27, 10, v6
    v_bfe_u32 v116, v1, 3, 2
    v_lshl_add_u32 v27, v116, 4, v27
    v_lshl_add_u32 v27, v115, 7, v27
    s_lshl_b32 s85, s80, 13
    s_lshr_b32 s83, s82, 1
    s_lshl_b32 s84, s83, 6
    s_add_u32 s85, s85, s84
    s_and_b32 s84, s3, 1
    s_lshl_b32 s87, s84, 8
    s_add_u32 s85, s85, s87
    s_add_u32 s85, s85, 0xb0000
    s_cmp_lt_u32 s80, 22
    s_cselect_b32 s85, s85, 0x7f000000
    v_add_u32 v27, s85, v27
    s_mul_i32 s85, s83, 160
    s_lshl_b32 s84, s84, 6
    s_add_u32 s85, s85, s84
    v_lshl_add_u32 v28, v112, 3, s85
    v_mov_b32 v34, s76
    v_mov_b32 v29, 0
    v_mov_b32 v30, 0
    v_mov_b32 v120, 0
    v_mov_b32 v40, s88
    v_mov_b32 v41, s88
    v_mov_b32 v42, s88
    v_mov_b32 v43, s88
    s_add_u32 s73, s73, 0x4000
    s_add_u32 m0, s74, 12672
    s_nop 0
    buffer_load_dwordx4 v4, s[8:11], s73 offen offset:0 lds
    s_add_u32 m0, s74, 12704
    s_nop 0
    buffer_load_dwordx4 v4, s[8:11], s73 offen offset:1024 lds
    s_add_u32 m0, s74, 12736
    s_nop 0
    buffer_load_dwordx4 v4, s[8:11], s73 offen offset:2048 lds
    s_add_u32 m0, s74, 12768
    s_nop 0
    buffer_load_dwordx4 v4, s[8:11], s73 offen offset:3072 lds
    s_xor_b32 s73, s73, 0x1c000
    s_add_u32 m0, s74, 67584
    s_nop 0
    buffer_load_dwordx4 v4, s[8:11], s73 offen offset:0 lds
    s_add_u32 m0, s74, 67616
    s_nop 0
    buffer_load_dwordx4 v4, s[8:11], s73 offen offset:1024 lds
    s_add_u32 m0, s74, 67648
    s_nop 0
    buffer_load_dwordx4 v4, s[8:11], s73 offen offset:2048 lds
    s_add_u32 m0, s74, 67680
    s_nop 0
    buffer_load_dwordx4 v4, s[8:11], s73 offen offset:3072 lds
    s_add_u32 s73, s73, 0x4000
    s_add_u32 m0, s74, 71808
    s_nop 0
    buffer_load_dwordx4 v4, s[8:11], s73 offen offset:0 lds
    s_add_u32 m0, s74, 71840
    s_nop 0
    buffer_load_dwordx4 v4, s[8:11], s73 offen offset:1024 lds
    s_add_u32 m0, s74, 71872
    s_nop 0
    buffer_load_dwordx4 v4, s[8:11], s73 offen offset:2048 lds
    s_add_u32 m0, s74, 71904
    s_nop 0
    buffer_load_dwordx4 v4, s[8:11], s73 offen offset:3072 lds
    s_add_u32 s73, s73, 0x4000
    s_add_u32 m0, s74, 76032
    s_nop 0
    buffer_load_dwordx4 v4, s[8:11], s73 offen offset:0 lds
    s_add_u32 m0, s74, 76064
    s_nop 0
    buffer_load_dwordx4 v4, s[8:11], s73 offen offset:1024 lds
    s_add_u32 m0, s74, 76096
    s_nop 0
    buffer_load_dwordx4 v4, s[8:11], s73 offen offset:2048 lds
    s_add_u32 m0, s74, 76128
    s_nop 0
    buffer_load_dwordx4 v4, s[8:11], s73 offen offset:3072 lds
    s_add_u32 s73, s73, 0x4000
    s_add_u32 m0, s74, 80256
    s_nop 0
    buffer_load_dwordx4 v4, s[8:11], s73 offen offset:0 lds
    s_add_u32 m0, s74, 80288
    s_nop 0
    buffer_load_dwordx4 v4, s[8:11], s73 offen offset:1024 lds
    s_add_u32 m0, s74, 80320
    s_nop 0
    buffer_load_dwordx4 v4, s[8:11], s73 offen offset:2048 lds
    s_add_u32 m0, s74, 80352
    s_nop 0
    buffer_load_dwordx4 v4, s[8:11], s73 offen offset:3072 lds
    s_movk_i32 s85, 0x2000
    buffer_load_dwordx4 v[52:55], v14, s[44:47], 0 offen offset:0 sc1
    buffer_load_dwordx4 v[56:59], v14, s[44:47], 0 offen offset:1024 sc1
    buffer_load_dwordx4 v[60:63], v14, s[44:47], s85 offen offset:0 sc1
    buffer_load_dwordx4 v[64:67], v14, s[44:47], s85 offen offset:1024 sc1
    s_waitcnt vmcnt(20)
L_pc_end:
    s_mov_b32 s86, 0x00010001
    s_lshl_b32 s83, s3, 12
    s_lshl4_add_u32 s83, s79, s83
    s_add_u32 s83, s83, 0x150000
    v_lshl_add_u32 v7, v112, 9, s83
    v_mov_b32 v9, 0
    s_waitcnt lgkmcnt(0)
    s_barrier
    ds_read_b32 v10, v9 offset:11140
    s_cmp_ge_u32 s3, 4
    s_cbranch_scc1 L_B_hi
    s_setprio 2
    ds_read_b128 v[128:131], v22 offset:0
    ds_read_b128 v[132:135], v22 offset:64
    ds_read_b128 v[136:139], v22 offset:128
    ds_read_b128 v[140:143], v22 offset:192
    ds_read_b128 v[144:147], v22 offset:256
    ds_read_b128 v[148:151], v22 offset:320
    ds_read_b128 v[152:155], v22 offset:384
    ds_read_b128 v[156:159], v22 offset:448
    ds_read_b128 v[160:163], v22 offset:512
L_stub_0:
    s_cbranch_execz L_stub_4
    ds_read_b128 v[164:167], v22 offset:576
    ds_read_b128 v[168:171], v22 offset:640
    ds_read_b128 v[172:175], v22 offset:704
    ds_read_b128 v[176:179], v22 offset:768
    ds_read_b128 v[180:183], v22 offset:832
    ds_read_b128 v[184:187], v22 offset:896
    ds_read_b128 v[188:191], v22 offset:960
    s_add_u32 m0, s95, 11200
    s_add_u32 s83, s75, 5504
    buffer_load_dwordx4 v120, s[28:31], s75 offen lds
    s_add_u32 m0, m0, 1056
    s_nop 0
    buffer_load_dwordx4 v120, s[28:31], s83 offen lds
    s_add_u32 m0, s95, 19648
    s_nop 0
    buffer_load_dwordx4 v120, s[32:35], s75 offen lds
    s_add_u32 m0, m0, 1056
    s_nop 0
    buffer_load_dwordx4 v120, s[32:35], s83 offen lds
    buffer_load_ushort v35, v28, s[4:7], 0 offen
    s_waitcnt lgkmcnt(0)
    v_readfirstlane_b32 s96, v10
    s_barrier
    ds_read_b128 v[80:83], v24 offset:0
    ds_read_b128 v[84:87], v24 offset:64
    ds_read_b128 v[88:91], v24 offset:128
    ds_read_b128 v[92:95], v24 offset:192
    ds_read_b128 v[96:99], v24 offset:256
    ds_read_b128 v[100:103], v24 offset:320
    ds_read_b128 v[104:107], v24 offset:384
    ds_read_b128 v[108:111], v24 offset:448
    ds_read_b128 v[192:195], v23 offset:0
    ds_read_b128 v[224:227], v23 offset:512
    ds_read_b128 v[196:199], v23 offset:64
    ds_read_b128 v[228:231], v23 offset:576
    ds_read_b128 v[200:203], v23 offset:128
    ds_read_b128 v[232:235], v23 offset:640
    s_waitcnt lgkmcnt(13)
    v_mfma_f32_16x16x32_bf16 v[52:55], v[128:131], v[80:83], 0
    v_mfma_f32_16x16x32_bf16 v[56:59], v[160:163], v[80:83], 0
    ds_read_b128 v[204:207], v23 offset:192
    s_waitcnt lgkmcnt(13)
    v_mfma_f32_16x16x32_bf16 v[52:55], v[132:135], v[84:87], v[52:55]
    v_mfma_f32_16x16x32_bf16 v[56:59], v[164:167], v[84:87], v[56:59]
    ds_read_b128 v[236:239], v23 offset:704
    s_waitcnt lgkmcnt(13)
    v_mfma_f32_16x16x32_bf16 v[52:55], v[136:139], v[88:91], v[52:55]
    v_mfma_f32_16x16x32_bf16 v[56:59], v[168:171], v[88:91], v[56:59]
    ds_read_b128 v[208:211], v23 offset:256
    s_waitcnt lgkmcnt(13)
    v_mfma_f32_16x16x32_bf16 v[52:55], v[140:143], v[92:95], v[52:55]
    v_mfma_f32_16x16x32_bf16 v[56:59], v[172:175], v[92:95], v[56:59]
    ds_read_b128 v[240:243], v23 offset:768
    s_waitcnt lgkmcnt(13)
    v_mfma_f32_16x16x32_bf16 v[52:55], v[144:147], v[96:99], v[52:55]
    v_mfma_f32_16x16x32_bf16 v[56:59], v[176:179], v[96:99], v[56:59]
    ds_read_b128 v[212:215], v23 offset:320
    s_waitcnt lgkmcnt(13)
    v_mfma_f32_16x16x32_bf16 v[52:55], v[148:151], v[100:103], v[52:55]
    v_mfma_f32_16x16x32_bf16 v[56:59], v[180:183], v[100:103], v[56:59]
    ds_read_b128 v[244:247], v23 offset:832
    ds_read_b128 v[216:219], v23 offset:384
    s_waitcnt lgkmcnt(14)
    v_mfma_f32_16x16x32_bf16 v[52:55], v[152:155], v[104:107], v[52:55]
    v_mfma_f32_16x16x32_bf16 v[56:59], v[184:187], v[104:107], v[56:59]
    ds_read_b128 v[248:251], v23 offset:896
    s_waitcnt lgkmcnt(14)
    v_mfma_f32_16x16x32_bf16 v[52:55], v[156:159], v[108:111], v[52:55]
    v_mfma_f32_16x16x32_bf16 v[56:59], v[188:191], v[108:111], v[56:59]
    ds_read_b128 v[220:223], v23 offset:448
    ds_read_b128 v[252:255], v23 offset:960
    s_waitcnt lgkmcnt(14)
    v_mfma_f32_16x16x32_bf16 v[60:63], v[192:195], v[80:83], 0
    v_mfma_f32_16x16x32_bf16 v[64:67], v[224:227], v[80:83], 0
    s_waitcnt lgkmcnt(12)
    v_mfma_f32_16x16x32_bf16 v[60:63], v[196:199], v[84:87], v[60:63]
    v_mfma_f32_16x16x32_bf16 v[64:67], v[228:231], v[84:87], v[64:67]
    s_waitcnt lgkmcnt(10)
    v_mfma_f32_16x16x32_bf16 v[60:63], v[200:203], v[88:91], v[60:63]
    v_mfma_f32_16x16x32_bf16 v[64:67], v[232:235], v[88:91], v[64:67]
    s_waitcnt lgkmcnt(8)
    v_mfma_f32_16x16x32_bf16 v[60:63], v[204:207], v[92:95], v[60:63]
    v_mfma_f32_16x16x32_bf16 v[64:67], v[236:239], v[92:95], v[64:67]
    s_waitcnt lgkmcnt(6)
    v_mfma_f32_16x16x32_bf16 v[60:63], v[208:211], v[96:99], v[60:63]
    v_mfma_f32_16x16x32_bf16 v[64:67], v[240:243], v[96:99], v[64:67]
    s_waitcnt lgkmcnt(4)
    v_mfma_f32_16x16x32_bf16 v[60:63], v[212:215], v[100:103], v[60:63]
    v_mfma_f32_16x16x32_bf16 v[64:67], v[244:247], v[100:103], v[64:67]
    s_waitcnt lgkmcnt(2)
    v_mfma_f32_16x16x32_bf16 v[60:63], v[216:219], v[104:107], v[60:63]
    v_mfma_f32_16x16x32_bf16 v[64:67], v[248:251], v[104:107], v[64:67]
    s_waitcnt lgkmcnt(0)
    v_mfma_f32_16x16x32_bf16 v[60:63], v[220:223], v[108:111], v[60:63]
    v_mfma_f32_16x16x32_bf16 v[64:67], v[252:255], v[108:111], v[64:67]
    v_add_f32_dpp v68, v56, v52 row_ror:8 row_mask:0xf bank_mask:0x3
    v_add_f32_dpp v69, v57, v53 row_ror:8 row_mask:0xf bank_mask:0x3
    v_add_f32_dpp v70, v58, v54 row_ror:8 row_mask:0xf bank_mask:0x3
    v_add_f32_dpp v71, v59, v55 row_ror:8 row_mask:0xf bank_mask:0x3
    s_nop 3
    v_add_f32_dpp v68, v60, v64 row_ror:8 row_mask:0xf bank_mask:0xc
    v_add_f32_dpp v69, v61, v65 row_ror:8 row_mask:0xf bank_mask:0xc
    v_add_f32_dpp v70, v62, v66 row_ror:8 row_mask:0xf bank_mask:0xc
    v_add_f32_dpp v71, v63, v67 row_ror:8 row_mask:0xf bank_mask:0xc
    v_max3_f32 v76, v68, v69, v70
    v_max_f32 v76, v76, v71
    s_nop 1
    v_max_f32_dpp v76, v76, v76 row_ror:8 row_mask:0xf bank_mask:0xf
    v_mov_b32 v77, v76
    s_nop 1
    v_permlane16_swap_b32 v76, v77
    v_max_f32 v76, v76, v77
    v_mov_b32 v77, v76
    s_nop 1
    v_permlane32_swap_b32 v76, v77
    v_max_f32 v76, v76, v77
    s_mov_b64 exec, 0xff
    ds_write_b32 v25, v76 offset:11008
    s_mov_b64 exec, -1
    s_waitcnt lgkmcnt(0)
    s_barrier
    ds_read_b128 v[52:55], v26 offset:11008
    s_waitcnt lgkmcnt(0)
    v_max3_f32 v76, v52, v53, v54
    v_max_f32 v76, v76, v55
    v_sub_f32 v68, v68, v76
    v_sub_f32 v69, v69, v76
    v_sub_f32 v70, v70, v76
    v_sub_f32 v71, v71, v76
    v_exp_f32 v68, v68
    v_exp_f32 v69, v69
    v_exp_f32 v70, v70
    v_exp_f32 v71, v71
    v_cvt_pk_bf16_f32 v52, v68, v69
    v_cvt_pk_bf16_f32 v53, v70, v71
    ds_write_b64 v27, v[52:53] offset:8704
    s_waitcnt lgkmcnt(0)
    s_barrier
    s_setprio 0
    v_mov_b32 v80, 0
    v_mov_b32 v81, 0
    v_mov_b32 v82, 0
    v_mov_b32 v83, 0
    v_mov_b32 v84, 0
    v_mov_b32 v85, 0
    v_mov_b32 v86, 0
    v_mov_b32 v87, 0
    v_mov_b32 v27, 0x7f000000
    s_bfe_u32 s84, s48, 0x20000
    s_mul_i32 s84, s84, 0x8001
    s_and_b32 s84, s84, s86
    v_mov_b32 v76, s84
    s_mov_b32 s58, s84
    s_bfe_u32 s84, s48, 0x20002
    s_mul_i32 s84, s84, 0x8001
    s_and_b32 s84, s84, s86
    v_mov_b32 v77, s84
    s_mov_b32 s59, s84
    s_bfe_u32 s84, s48, 0x20004
L_stub_1:
    s_cbranch_execz L_stub_5
    s_mul_i32 s84, s84, 0x8001
    s_and_b32 s84, s84, s86
    v_mov_b32 v78, s84
    s_bfe_u32 s84, s48, 0x20006
    s_mul_i32 s84, s84, 0x8001
    s_and_b32 s84, s84, s86
    v_mov_b32 v79, s84
    s_lshl3_add_u32 s84, s81, s3
    s_lshl_b32 s84, s84, 10
    s_add_u32 s84, s84, 0x200000
    s_add_u32 s56, s44, s84
    s_addc_u32 s57, s45, 0
    s_mov_b32 s60, s86
    s_mov_b32 s61, s86
    s_cmp_ge_u32 s80, 22
    s_cbranch_scc1 L_B_end
    v_mov_b32 v9, 0
    v_mov_b32 v10, 1
    s_waitcnt vmcnt(0)
    s_mov_b64 exec, 1
    ds_add_u32 v9, v10 offset:11136
    s_mov_b64 exec, -1
    s_mov_b32 s87, 0
L_cw:
    s_sleep 1
    ds_read_b32 v10, v9 offset:11136
    s_add_u32 s87, s87, 1
    s_cmp_gt_u32 s87, 20000
    s_cbranch_scc1 L_END
    s_waitcnt lgkmcnt(0)
    v_cmp_ne_u32 vcc, 4, v10
    s_cbranch_vccnz L_cw
    ds_read_b64_tr_b16 v[88:89], v30 offset:0
    ds_read_b64_tr_b16 v[90:91], v30 offset:128
    ds_read_b64_tr_b16 v[92:93], v30 offset:256
    ds_read_b64_tr_b16 v[94:95], v30 offset:384
    ds_read_b64_tr_b16 v[96:97], v30 offset:8448
    ds_read_b64_tr_b16 v[98:99], v30 offset:8576
    ds_read_b64_tr_b16 v[100:101], v30 offset:8704
    ds_read_b64_tr_b16 v[102:103], v30 offset:8832
    v_mov_b32 v60, s48
    v_mov_b32 v61, s49
    s_waitcnt lgkmcnt(4)
    v_mfma_f32_16x16x32_bf16 v[52:55], v[88:91], v[40:43], 0
    v_mfma_f32_16x16x32_bf16 v[64:67], v[88:91], v[124:127], 0
    v_mfma_f32_16x16x32_bf16 v[52:55], v[92:95], v[44:47], v[52:55]
    v_mfma_f32_16x16x32_bf16 v[64:67], v[92:95], v[124:127], v[64:67]
    s_waitcnt lgkmcnt(0)
    v_mfma_f32_16x16x32_bf16 v[56:59], v[96:99], v[40:43], 0
    v_mfma_f32_16x16x32_bf16 v[68:71], v[96:99], v[124:127], 0
    v_mfma_f32_16x16x32_bf16 v[56:59], v[100:103], v[44:47], v[56:59]
    v_mfma_f32_16x16x32_bf16 v[68:71], v[100:103], v[124:127], v[68:71]
    s_nop 2
    v_fmac_f32 v52, v64, v36
    v_fmac_f32 v53, v65, v36
    v_fmac_f32 v54, v66, v36
    v_fmac_f32 v55, v67, v36
    s_nop 0
    v_fmac_f32 v56, v68, v36
    v_fmac_f32 v57, v69, v36
    v_fmac_f32 v58, v70, v36
    v_fmac_f32 v59, v71, v36
    v_cvt_pk_bf16_f32 v50, v52, v53
    v_cvt_pk_bf16_f32 v51, v54, v55
    v_cvt_pk_bf16_f32 v62, v56, v57
    v_cvt_pk_bf16_f32 v63, v58, v59
    s_mov_b64 exec, s[64:65]
    s_cmp_eq_u32 s96, 0
    s_cbranch_scc1 L_ls_3
    buffer_store_dwordx4 v[48:51], v13, s[44:47], s77 offen
    buffer_store_dwordx4 v[60:63], v13, s[44:47], s77 offen offset:512
    s_branch L_ls_4
L_ls_3:
    buffer_store_dwordx4 v[48:51], v13, s[44:47], s77 offen sc1
    buffer_store_dwordx4 v[60:63], v13, s[44:47], s77 offen offset:512 sc1
L_ls_4:
    s_mov_b64 exec, -1
    s_branch L_B_end
L_B_hi:
    s_setprio 1
    ds_read_b64_tr_b16 v[128:129], v22 offset:0
    ds_read_b64_tr_b16 v[132:133], v22 offset:16896
    ds_read_b64_tr_b16 v[136:137], v22 offset:33792
    ds_read_b64_tr_b16 v[140:141], v22 offset:50688
    ds_read_b64_tr_b16 v[144:145], v22 offset:32
    ds_read_b64_tr_b16 v[148:149], v22 offset:16928
    ds_read_b64_tr_b16 v[152:153], v22 offset:33824
    ds_read_b64_tr_b16 v[156:157], v22 offset:50720
    ds_read_b64_tr_b16 v[160:161], v22 offset:64
    ds_read_b64_tr_b16 v[164:165], v22 offset:16960
    ds_read_b64_tr_b16 v[168:169], v22 offset:33856
    ds_read_b64_tr_b16 v[172:173], v22 offset:50752
    ds_read_b64_tr_b16 v[176:177], v22 offset:96
    ds_read_b64_tr_b16 v[180:181], v22 offset:16992
    ds_read_b64_tr_b16 v[184:185], v22 offset:33888
    ds_read_b64_tr_b16 v[188:189], v22 offset:50784
    ds_read_b64_tr_b16 v[192:193], v22 offset:128
    ds_read_b64_tr_b16 v[196:197], v22 offset:17024
    ds_read_b64_tr_b16 v[200:201], v22 offset:33920
    ds_read_b64_tr_b16 v[204:205], v22 offset:50816
    ds_read_b64_tr_b16 v[208:209], v22 offset:160
    ds_read_b64_tr_b16 v[212:213], v22 offset:17056
    ds_read_b64_tr_b16 v[216:217], v22 offset:33952
    ds_read_b64_tr_b16 v[220:221], v22 offset:50848
    ds_read_b64_tr_b16 v[224:225], v22 offset:192
    ds_read_b64_tr_b16 v[228:229], v22 offset:17088
    ds_read_b64_tr_b16 v[232:233], v22 offset:33984
    ds_read_b64_tr_b16 v[236:237], v22 offset:50880
    ds_read_b64_tr_b16 v[240:241], v22 offset:224
    ds_read_b64_tr_b16 v[244:245], v22 offset:17120
    ds_read_b64_tr_b16 v[248:249], v22 offset:34016
    ds_read_b64_tr_b16 v[252:253], v22 offset:50912
    s_waitcnt vmcnt(0)
    v_cmp_ne_u64 vcc, s[48:49], v[52:53]
    v_cmp_ne_u64 s[50:51], s[48:49], v[56:57]
    s_nop 0
    s_or_b64 vcc, vcc, s[50:51]
    v_cmp_ne_u64 s[50:51], s[48:49], v[60:61]
    s_nop 0
    s_or_b64 vcc, vcc, s[50:51]
    v_cmp_ne_u64 s[50:51], s[48:49], v[64:65]
    s_nop 0
    s_or_b64 vcc, vcc, s[50:51]
    s_cbranch_scc0 L_done_h1_6
    s_mov_b32 s87, 0
L_retry_h1_5:
    s_add_u32 s87, s87, 1
    s_cmp_gt_u32 s87, 20000
    s_cbranch_scc1 L_END
    buffer_load_dwordx4 v[52:55], v14, s[44:47], 0 offen offset:0 sc1
    buffer_load_dwordx4 v[56:59], v14, s[44:47], 0 offen offset:1024 sc1
    buffer_load_dwordx4 v[60:63], v14, s[44:47], s85 offen offset:0 sc1
    buffer_load_dwordx4 v[64:67], v14, s[44:47], s85 offen offset:1024 sc1
    s_waitcnt vmcnt(0)
    v_cmp_ne_u64 vcc, s[48:49], v[52:53]
    v_cmp_ne_u64 s[50:51], s[48:49], v[56:57]
    s_nop 0
    s_or_b64 vcc, vcc, s[50:51]
    v_cmp_ne_u64 s[50:51], s[48:49], v[60:61]
    s_nop 0
    s_or_b64 vcc, vcc, s[50:51]
    v_cmp_ne_u64 s[50:51], s[48:49], v[64:65]
    s_nop 0
    s_or_b64 vcc, vcc, s[50:51]
    s_cbranch_scc1 L_retry_h1_5
L_done_h1_6:
    ds_write_b64 v15, v[54:55] offset:0
    ds_write_b64 v15, v[58:59] offset:4352
    ds_write_b64 v15, v[62:63] offset:2176
    ds_write_b64 v15, v[66:67] offset:6528
    s_waitcnt lgkmcnt(0)
    v_readfirstlane_b32 s96, v10
    s_barrier
    s_lshl1_add_u32 m0, s95, 28096
    s_nop 0
    buffer_load_dwordx4 v8, s[20:23], s92 offen lds
    s_add_u32 m0, m0, 1056
    s_add_u32 s92, s92, 8192
    buffer_load_dwordx4 v8, s[20:23], s92 offen lds
    s_add_u32 m0, m0, 1056
    s_add_u32 s92, s92, 8192
    buffer_load_dwordx4 v8, s[20:23], s92 offen lds
    s_add_u32 m0, m0, 1056
    s_add_u32 s92, s92, 8192
    buffer_load_dwordx4 v8, s[20:23], s92 offen lds
    ds_read_b64_tr_b16 v[130:131], v23 offset:0
    ds_read_b64_tr_b16 v[134:135], v23 offset:16896
    ds_read_b64_tr_b16 v[138:139], v23 offset:33792
    ds_read_b64_tr_b16 v[142:143], v23 offset:50688
L_stub_2:
    s_cbranch_execz L_back
    ds_read_b64_tr_b16 v[146:147], v23 offset:32
    ds_read_b64_tr_b16 v[150:151], v23 offset:16928
    ds_read_b64_tr_b16 v[154:155], v23 offset:33824
    ds_read_b64_tr_b16 v[158:159], v23 offset:50720
    ds_read_b64_tr_b16 v[162:163], v23 offset:64
    ds_read_b64_tr_b16 v[166:167], v23 offset:16960
    ds_read_b64_tr_b16 v[170:171], v23 offset:33856
    ds_read_b64_tr_b16 v[174:175], v23 offset:50752
    ds_read_b64_tr_b16 v[178:179], v23 offset:96
    ds_read_b64_tr_b16 v[182:183], v23 offset:16992
    ds_read_b64_tr_b16 v[186:187], v23 offset:33888
    ds_read_b64_tr_b16 v[190:191], v23 offset:50784
    ds_read_b64_tr_b16 v[194:195], v23 offset:128
    ds_read_b64_tr_b16 v[198:199], v23 offset:17024
    ds_read_b64_tr_b16 v[202:203], v23 offset:33920
    ds_read_b64_tr_b16 v[206:207], v23 offset:50816
    ds_read_b64_tr_b16 v[210:211], v23 offset:160
    ds_read_b64_tr_b16 v[214:215], v23 offset:17056
    ds_read_b64_tr_b16 v[218:219], v23 offset:33952
    ds_read_b64_tr_b16 v[222:223], v23 offset:50848
    ds_read_b64_tr_b16 v[226:227], v23 offset:192
    ds_read_b64_tr_b16 v[230:231], v23 offset:17088
    ds_read_b64_tr_b16 v[234:235], v23 offset:33984
    ds_read_b64_tr_b16 v[238:239], v23 offset:50880
    ds_read_b64_tr_b16 v[242:243], v23 offset:224
    ds_read_b64_tr_b16 v[246:247], v23 offset:17120
    ds_read_b64_tr_b16 v[250:251], v23 offset:34016
    ds_read_b64_tr_b16 v[254:255], v23 offset:50912
    s_bfe_u32 s84, s48, 0x20000
    s_mul_i32 s84, s84, 0x8001
    s_and_b32 s84, s84, s86
    v_mov_b32 v76, s84
    s_mov_b32 s58, s84
    s_bfe_u32 s84, s48, 0x20002
    s_mul_i32 s84, s84, 0x8001
    s_and_b32 s84, s84, s86
    v_mov_b32 v77, s84
    s_mov_b32 s59, s84
    s_bfe_u32 s84, s48, 0x20004
    s_mul_i32 s84, s84, 0x8001
    s_and_b32 s84, s84, s86
    v_mov_b32 v78, s84
    s_bfe_u32 s84, s48, 0x20006
    s_mul_i32 s84, s84, 0x8001
    s_and_b32 s84, s84, s86
    v_mov_b32 v79, s84
    s_lshl3_add_u32 s84, s81, s3
    s_lshl_b32 s84, s84, 10
    s_add_u32 s84, s84, 0x200000
    s_add_u32 s56, s44, s84
    s_addc_u32 s57, s45, 0
    s_mov_b32 s60, s86
    s_mov_b32 s61, s86
    v_mov_b32 v62, s48
    v_mov_b32 v63, s49
    s_movk_i32 s83, 0x2000
    s_lshl2_add_u32 s84, s72, s71
    s_lshl_b32 s84, s84, 7
    s_add_u32 s84, s84, 0x150000
    s_cmp_eq_u32 s3, 4
    s_cselect_b32 s84, s84, 0x7f000000
    s_barrier
    ds_read_b128 v[68:71], v26 offset:11008
    s_waitcnt lgkmcnt(0)
    v_max3_f32 v60, v68, v69, v70
    v_max_f32 v60, v60, v71
    s_barrier
    ds_read_b128 v[112:115], v24 offset:8704
    ds_read_b128 v[116:119], v24 offset:8768
    ds_read_b128 v[120:123], v24 offset:8832
    ds_read_b128 v[124:127], v24 offset:8896
    s_waitcnt lgkmcnt(3)
    v_mfma_f32_16x16x32_bf16 v[80:83], v[128:131], v[112:115], 0
    v_mfma_f32_16x16x32_bf16 v[84:87], v[144:147], v[112:115], 0
    v_mfma_f32_16x16x32_bf16 v[72:75], v[40:43], v[112:115], 0
    s_waitcnt lgkmcnt(2)
    v_mfma_f32_16x16x32_bf16 v[80:83], v[132:135], v[116:119], v[80:83]
    v_mfma_f32_16x16x32_bf16 v[84:87], v[148:151], v[116:119], v[84:87]
    v_mfma_f32_16x16x32_bf16 v[72:75], v[40:43], v[116:119], v[72:75]
    s_waitcnt lgkmcnt(1)
    v_mfma_f32_16x16x32_bf16 v[80:83], v[136:139], v[120:123], v[80:83]
    v_mfma_f32_16x16x32_bf16 v[84:87], v[152:155], v[120:123], v[84:87]
    v_mfma_f32_16x16x32_bf16 v[72:75], v[40:43], v[120:123], v[72:75]
    s_waitcnt lgkmcnt(0)
    v_mfma_f32_16x16x32_bf16 v[80:83], v[140:143], v[124:127], v[80:83]
    v_mfma_f32_16x16x32_bf16 v[84:87], v[156:159], v[124:127], v[84:87]
    v_mfma_f32_16x16x32_bf16 v[72:75], v[40:43], v[124:127], v[72:75]
    v_mfma_f32_16x16x32_bf16 v[88:91], v[160:163], v[112:115], 0
    v_mfma_f32_16x16x32_bf16 v[92:95], v[176:179], v[112:115], 0
    v_mfma_f32_16x16x32_bf16 v[88:91], v[164:167], v[116:119], v[88:91]
    v_mfma_f32_16x16x32_bf16 v[92:95], v[180:183], v[116:119], v[92:95]
    v_mfma_f32_16x16x32_bf16 v[88:91], v[168:171], v[120:123], v[88:91]
    s_nop 1
    v_cndmask_b32 v68, v80, v84, s[62:63]
    v_cndmask_b32 v69, v81, v85, s[62:63]
    v_mfma_f32_16x16x32_bf16 v[92:95], v[184:187], v[120:123], v[92:95]
    v_cndmask_b32 v70, v82, v86, s[62:63]
    v_cndmask_b32 v71, v83, v87, s[62:63]
    v_mfma_f32_16x16x32_bf16 v[88:91], v[172:175], v[124:127], v[88:91]
    v_cvt_pk_bf16_f32 v52, v68, v69
    v_cvt_pk_bf16_f32 v53, v70, v71
    v_mfma_f32_16x16x32_bf16 v[92:95], v[188:191], v[124:127], v[92:95]
    v_bfi_b32 v52, s86, v76, v52
    v_bfi_b32 v53, s86, v77, v53
    v_mov_b32 v61, v72
    s_mov_b64 exec, 0xff
    buffer_store_dwordx4 v[60:63], v4, s[44:47], s84 offen sc1
    s_mov_b64 exec, -1
    v_mfma_f32_16x16x32_bf16 v[96:99], v[192:195], v[112:115], 0
    v_mfma_f32_16x16x32_bf16 v[100:103], v[208:211], v[112:115], 0
    v_mfma_f32_16x16x32_bf16 v[96:99], v[196:199], v[116:119], v[96:99]
    v_mfma_f32_16x16x32_bf16 v[100:103], v[212:215], v[116:119], v[100:103]
    v_mfma_f32_16x16x32_bf16 v[96:99], v[200:203], v[120:123], v[96:99]
    v_cndmask_b32 v68, v88, v92, s[62:63]
    v_cndmask_b32 v69, v89, v93, s[62:63]
    v_mfma_f32_16x16x32_bf16 v[100:103], v[216:219], v[120:123], v[100:103]
    v_cndmask_b32 v70, v90, v94, s[62:63]
    v_cndmask_b32 v71, v91, v95, s[62:63]
    v_mfma_f32_16x16x32_bf16 v[96:99], v[204:207], v[124:127], v[96:99]
    v_cvt_pk_bf16_f32 v54, v68, v69
    v_cvt_pk_bf16_f32 v55, v70, v71
    v_mfma_f32_16x16x32_bf16 v[100:103], v[220:223], v[124:127], v[100:103]
    v_bfi_b32 v54, s86, v78, v54
    v_bfi_b32 v55, s86, v79, v55
    v_mfma_f32_16x16x32_bf16 v[104:107], v[224:227], v[112:115], 0
    buffer_store_dwordx4 v[52:55], v25, s[44:47], 0 offen sc1
    v_mfma_f32_16x16x32_bf16 v[108:111], v[240:243], v[112:115], 0
    v_mfma_f32_16x16x32_bf16 v[104:107], v[228:231], v[116:119], v[104:107]
    v_mfma_f32_16x16x32_bf16 v[108:111], v[244:247], v[116:119], v[108:111]
    v_mfma_f32_16x16x32_bf16 v[104:107], v[232:235], v[120:123], v[104:107]
    v_cndmask_b32 v68, v96, v100, s[62:63]
    v_cndmask_b32 v69, v97, v101, s[62:63]
    v_mfma_f32_16x16x32_bf16 v[108:111], v[248:251], v[120:123], v[108:111]
    v_cndmask_b32 v70, v98, v102, s[62:63]
    v_cndmask_b32 v71, v99, v103, s[62:63]
    v_mfma_f32_16x16x32_bf16 v[104:107], v[236:239], v[124:127], v[104:107]
    v_cvt_pk_bf16_f32 v56, v68, v69
    v_cvt_pk_bf16_f32 v57, v70, v71
    v_mfma_f32_16x16x32_bf16 v[108:111], v[252:255], v[124:127], v[108:111]
    v_bfi_b32 v56, s86, v76, v56
    v_bfi_b32 v57, s86, v77, v57
    s_nop 5
    v_cndmask_b32 v68, v104, v108, s[62:63]
    v_cndmask_b32 v69, v105, v109, s[62:63]
L_stub_3:
    s_cbranch_execz L_back
    v_cndmask_b32 v70, v106, v110, s[62:63]
    v_cndmask_b32 v71, v107, v111, s[62:63]
    v_cvt_pk_bf16_f32 v58, v68, v69
    v_cvt_pk_bf16_f32 v59, v70, v71
    v_bfi_b32 v58, s86, v78, v58
    v_bfi_b32 v59, s86, v79, v59
    buffer_store_dwordx4 v[56:59], v25, s[44:47], s83 offen sc1
    s_setprio 0
    s_waitcnt vmcnt(0)
L_B_end:
    s_barrier
    s_mov_b32 s85, 0xffff0000
    v_mov_b32 v73, 0x8000
    buffer_load_dwordx4 v[104:107], v16, s[44:47], 0 offen sc1
    buffer_load_dwordx4 v[108:111], v7, s[44:47], 0 offen sc1
    ds_read_b64_tr_b16 v[96:97], v12 offset:28096
    ds_read_b64_tr_b16 v[98:99], v12 offset:28352
    ds_read_b64_tr_b16 v[100:101], v12 offset:28608
    ds_read_b64_tr_b16 v[102:103], v12 offset:28864
    s_barrier
    s_add_u32 m0, s94, 44992
    s_nop 0
    buffer_load_dwordx4 v20, s[24:27], 0 offen lds
    s_add_u32 m0, m0, 32
    s_lshr_b32 s84, s94, 1
    buffer_load_dwordx4 v20, s[24:27], 0 offen offset:1024 lds
    s_add_u32 m0, s84, 61888
    s_nop 0
    buffer_load_dwordx4 v21, s[36:39], 0 offen lds
    s_waitcnt vmcnt(3)
    v_xor_b32 v104, v104, v76
    v_xor_b32 v105, v105, v77
    v_xor_b32 v106, v106, v78
    v_xor_b32 v107, v107, v79
    v_or3_b32 v72, v104, v105, v106
    v_bitop3_b32 v72, v72, v107, s86 bitop3:0xa8
    v_cmp_ne_u32 vcc, 0, v72
    v_cmp_ne_u64 s[50:51], s[48:49], v[110:111]
    s_nop 0
    s_or_b64 vcc, vcc, s[50:51]
    s_cbranch_scc0 L_done_h2_8
    s_mov_b32 s87, 0
L_retry_h2_7:
    s_add_u32 s87, s87, 1
    s_cmp_gt_u32 s87, 20000
    s_cbranch_scc1 L_END
    buffer_load_dwordx4 v[104:107], v16, s[44:47], 0 offen sc1
    buffer_load_dwordx4 v[108:111], v7, s[44:47], 0 offen sc1
    s_waitcnt vmcnt(0)
    v_xor_b32 v104, v104, v76
    v_xor_b32 v105, v105, v77
    v_xor_b32 v106, v106, v78
    v_xor_b32 v107, v107, v79
    v_or3_b32 v72, v104, v105, v106
    v_bitop3_b32 v72, v72, v107, s86 bitop3:0xa8
    v_cmp_ne_u32 vcc, 0, v72
    v_cmp_ne_u64 s[50:51], s[48:49], v[110:111]
    s_nop 0
    s_or_b64 vcc, vcc, s[50:51]
    s_cbranch_scc1 L_retry_h2_7
L_done_h2_8:
    v_max_f32_dpp v60, v108, v108 row_ror:8 row_mask:0xf bank_mask:0xf
    v_lshl_or_b32 v52, v104, 16, v73
    v_and_or_b32 v53, v104, s85, v73
    v_lshl_or_b32 v56, v106, 16, v73
    v_and_or_b32 v57, v106, s85, v73
    v_mov_b32 v62, v60
    v_lshl_or_b32 v54, v105, 16, v73
    v_and_or_b32 v55, v105, s85, v73
    v_permlane16_swap_b32 v60, v62
    v_max_f32 v60, v60, v62
    v_mov_b32 v62, v60
    v_lshl_or_b32 v58, v107, 16, v73
    v_and_or_b32 v59, v107, s85, v73
    v_permlane32_swap_b32 v60, v62
    v_max_f32 v60, v60, v62
    v_sub_f32 v61, v108, v60
    v_exp_f32 v61, v61
    s_nop 0
    v_mul_f32 v52, v52, v61
    v_mul_f32 v53, v53, v61
    v_mul_f32 v54, v54, v61
    v_mul_f32 v55, v55, v61
    v_mul_f32 v56, v56, v61
    v_mul_f32 v57, v57, v61
    v_mul_f32 v58, v58, v61
    v_mul_f32 v59, v59, v61
    v_mul_f32 v61, v109, v61
    v_permlane16_swap_b32 v52, v56
    v_permlane16_swap_b32 v53, v57
    v_permlane16_swap_b32 v54, v58
    v_permlane16_swap_b32 v55, v59
    v_add_f32 v52, v52, v56
    v_add_f32 v53, v53, v57
    v_add_f32 v54, v54, v58
    v_add_f32 v55, v55, v59
    v_add_f32_dpp v61, v61, v61 row_ror:8 row_mask:0xf bank_mask:0xf
    v_permlane32_swap_b32 v52, v54
    v_permlane32_swap_b32 v53, v55
    v_mov_b32 v62, v61
    v_add_f32 v52, v52, v54
    v_add_f32 v53, v53, v55
    v_permlane16_swap_b32 v61, v62
    v_add_f32_dpp v52, v52, v52 row_ror:8 row_mask:0xf bank_mask:0xf
    v_add_f32_dpp v53, v53, v53 row_ror:8 row_mask:0xf bank_mask:0xf
    v_add_f32 v61, v61, v62
    v_cvt_pk_bf16_f32 v52, v52, v53
    v_mov_b32 v62, v61
    s_mov_b64 exec, s[54:55]
    ds_write_b32 v17, v52 offset:4608
    s_mov_b64 exec, -1
    v_permlane32_swap_b32 v61, v62
    v_add_f32 v61, v61, v62
    s_mov_b64 exec, 1
    ds_write_b64 v17, v[60:61] offset:4736
    s_mov_b64 exec, -1
    s_waitcnt lgkmcnt(0)
    s_barrier
    buffer_load_dwordx4 v[112:115], v27, s[44:47], 0 offen offset:0 sc1
    buffer_load_dwordx4 v[116:119], v27, s[44:47], 0 offen offset:512 sc1
    ds_read_b64 v[60:61], v19 offset:4736
    ds_read_b128 v[120:123], v18 offset:4608
    ds_read_b128 v[124:127], v18 offset:4672
    s_waitcnt lgkmcnt(2)
    v_max_f32_dpp v63, v60, v60 row_ror:4 row_mask:0xf bank_mask:0xf
    s_nop 1
    v_max_f32_dpp v63, v63, v63 row_ror:2 row_mask:0xf bank_mask:0xf
    s_waitcnt lgkmcnt(0)
    v_mfma_f32_16x16x32_bf16 v[52:55], v[96:99], v[120:123], 0
    v_mfma_f32_16x16x32_bf16 v[52:55], v[100:103], v[124:127], v[52:55]
    v_sub_f32 v64, v60, v63
    v_exp_f32 v64, v64
    s_nop 0
    v_mul_f32 v61, v61, v64
    s_nop 1
    v_add_f32_dpp v61, v61, v61 row_ror:4 row_mask:0xf bank_mask:0xf
    s_nop 1
    v_add_f32_dpp v61, v61, v61 row_ror:2 row_mask:0xf bank_mask:0xf
    v_rcp_f32 v61, v61
    s_nop 0
    v_mul_f32 v64, v64, v61
    v_mul_f32 v52, v52, v64
    v_mul_f32 v53, v53, v64
    v_mul_f32 v54, v54, v64
    v_mul_f32 v55, v55, v64
    v_add_f32_dpp v52, v52, v52 row_ror:4 row_mask:0xf bank_mask:0xf
    v_add_f32_dpp v53, v53, v53 row_ror:4 row_mask:0xf bank_mask:0xf
    v_add_f32_dpp v54, v54, v54 row_ror:4 row_mask:0xf bank_mask:0xf
    v_add_f32_dpp v55, v55, v55 row_ror:4 row_mask:0xf bank_mask:0xf
    v_add_f32_dpp v52, v52, v52 row_ror:2 row_mask:0xf bank_mask:0xf
    v_add_f32_dpp v53, v53, v53 row_ror:2 row_mask:0xf bank_mask:0xf
    v_add_f32_dpp v54, v54, v54 row_ror:2 row_mask:0xf bank_mask:0xf
    v_add_f32_dpp v55, v55, v55 row_ror:2 row_mask:0xf bank_mask:0xf
    v_cvt_pk_bf16_f32 v50, v52, v53
    v_cvt_pk_bf16_f32 v51, v54, v55
    s_mov_b64 exec, s[52:53]
    s_cmp_eq_u32 s96, 0
    s_cbranch_scc1 L_ls_9
    buffer_store_dwordx4 v[48:51], v13, s[44:47], s89 offen
    s_branch L_ls_10
L_ls_9:
    buffer_store_dwordx4 v[48:51], v13, s[44:47], s89 offen sc1
L_ls_10:
    s_mov_b64 exec, -1
    s_cmp_ge_u32 s3, 4
    s_cbranch_scc1 L_f2
    s_add_u32 s85, s90, 4096
    s_waitcnt vmcnt(3)
    s_barrier
    buffer_load_dwordx4 v[104:107], v4, s[44:47], s90 offen sc1
    buffer_load_dwordx4 v[108:111], v4, s[44:47], s85 offen sc1
    ds_read_b64_tr_b16 v[128:129], v12 offset:44992
    ds_read_b64_tr_b16 v[130:131], v12 offset:45120
    ds_read_b64_tr_b16 v[132:133], v12 offset:45248
    ds_read_b64_tr_b16 v[134:135], v12 offset:45376
    ds_read_b64_tr_b16 v[136:137], v12 offset:45504
    ds_read_b64_tr_b16 v[138:139], v12 offset:45632
    ds_read_b64_tr_b16 v[140:141], v12 offset:45760
    ds_read_b64_tr_b16 v[142:143], v12 offset:45888
    ds_read_b64_tr_b16 v[144:145], v30 offset:50688
    ds_read_b64_tr_b16 v[146:147], v30 offset:50816
L_stub_4:
    s_cbranch_execz L_back
    ds_read_b64_tr_b16 v[148:149], v30 offset:50944
    ds_read_b64_tr_b16 v[150:151], v30 offset:51072
    s_waitcnt vmcnt(0)
    v_cmp_ne_u64 vcc, s[48:49], v[104:105]
    v_cmp_ne_u64 s[50:51], s[48:49], v[108:109]
    s_nop 0
    s_or_b64 vcc, vcc, s[50:51]
    s_cbranch_scc0 L_done_h25_12
    s_mov_b32 s87, 0
L_retry_h25_11:
    s_add_u32 s87, s87, 1
    s_cmp_gt_u32 s87, 20000
    s_cbranch_scc1 L_END
    buffer_load_dwordx4 v[104:107], v4, s[44:47], s90 offen sc1
    buffer_load_dwordx4 v[108:111], v4, s[44:47], s85 offen sc1
    s_waitcnt vmcnt(0)
    v_cmp_ne_u64 vcc, s[48:49], v[104:105]
    v_cmp_ne_u64 s[50:51], s[48:49], v[108:109]
    s_nop 0
    s_or_b64 vcc, vcc, s[50:51]
    s_cbranch_scc1 L_retry_h25_11
L_done_h25_12:
    ds_write_b64 v31, v[106:107] offset:0
    ds_write_b64 v31, v[110:111] offset:2304
    s_waitcnt lgkmcnt(0)
    s_barrier
    ds_read_b128 v[152:155], v32 offset:0
    ds_read_b128 v[156:159], v32 offset:64
    ds_read_b128 v[160:163], v32 offset:128
    ds_read_b128 v[164:167], v32 offset:192
    s_cmp_ge_u32 s80, 22
    s_cbranch_scc1 L_d_nof
    s_mov_b64 exec, s[52:53]
    ds_read_b128 v[80:83], v29 offset:6144
    ds_read_b128 v[84:87], v29 offset:6208
    s_mov_b64 exec, -1
L_d_nof:
    s_waitcnt lgkmcnt(0)
    v_mfma_f32_16x16x32_bf16 v[52:55], v[128:131], v[152:155], 0
    v_mfma_f32_16x16x32_bf16 v[52:55], v[132:135], v[156:159], v[52:55]
    v_mfma_f32_16x16x32_bf16 v[52:55], v[136:139], v[160:163], v[52:55]
    v_mfma_f32_16x16x32_bf16 v[52:55], v[140:143], v[164:167], v[52:55]
    v_mfma_f32_16x16x32_bf16 v[52:55], v[144:147], v[80:83], v[52:55]
    v_mfma_f32_16x16x32_bf16 v[52:55], v[148:151], v[84:87], v[52:55]
    s_nop 7
    v_add_f32_dpp v52, v52, v52 row_ror:8 row_mask:0xf bank_mask:0xf
    v_add_f32_dpp v53, v53, v53 row_ror:8 row_mask:0xf bank_mask:0xf
    v_add_f32_dpp v54, v54, v54 row_ror:8 row_mask:0xf bank_mask:0xf
    v_add_f32_dpp v55, v55, v55 row_ror:8 row_mask:0xf bank_mask:0xf
    v_add_f32_dpp v52, v52, v52 row_ror:4 row_mask:0xf bank_mask:0xf
    v_add_f32_dpp v53, v53, v53 row_ror:4 row_mask:0xf bank_mask:0xf
    v_add_f32_dpp v54, v54, v54 row_ror:4 row_mask:0xf bank_mask:0xf
    v_add_f32_dpp v55, v55, v55 row_ror:4 row_mask:0xf bank_mask:0xf
    v_add_f32_dpp v52, v52, v52 row_ror:2 row_mask:0xf bank_mask:0xf
    v_add_f32_dpp v53, v53, v53 row_ror:2 row_mask:0xf bank_mask:0xf
    v_add_f32_dpp v54, v54, v54 row_ror:2 row_mask:0xf bank_mask:0xf
    v_add_f32_dpp v55, v55, v55 row_ror:2 row_mask:0xf bank_mask:0xf
    v_cvt_pk_bf16_f32 v50, v52, v53
    v_cvt_pk_bf16_f32 v51, v54, v55
    s_mov_b64 exec, s[52:53]
    buffer_store_dwordx4 v[48:51], v13, s[44:47], s91 offen sc1
    s_mov_b64 exec, -1
    s_branch L_fin
L_f2:
    s_waitcnt vmcnt(3)
    s_barrier
    s_cmp_ge_u32 s80, 22
    s_cbranch_scc1 L_b7
    s_waitcnt vmcnt(1)
    v_cmp_ne_u64 vcc, s[48:49], v[112:113]
    v_cmp_ne_u64 s[50:51], s[48:49], v[116:117]
    s_nop 0
    s_or_b64 vcc, vcc, s[50:51]
    s_cbranch_scc0 L_done_hf_14
    s_mov_b32 s87, 0
L_retry_hf_13:
    s_add_u32 s87, s87, 1
    s_cmp_gt_u32 s87, 20000
    s_cbranch_scc1 L_END
    buffer_load_dwordx4 v[112:115], v27, s[44:47], 0 offen offset:0 sc1
    buffer_load_dwordx4 v[116:119], v27, s[44:47], 0 offen offset:512 sc1
    s_waitcnt vmcnt(0)
    v_cmp_ne_u64 vcc, s[48:49], v[112:113]
    v_cmp_ne_u64 s[50:51], s[48:49], v[116:117]
    s_nop 0
    s_or_b64 vcc, vcc, s[50:51]
    s_cbranch_scc1 L_retry_hf_13
L_done_hf_14:
    v_lshlrev_b32 v52, 16, v114
    v_and_b32 v53, 0xffff0000, v114
    v_lshlrev_b32 v54, 16, v115
    v_and_b32 v55, 0xffff0000, v115
    v_lshlrev_b32 v56, 16, v118
    v_and_b32 v57, 0xffff0000, v118
    v_lshlrev_b32 v58, 16, v119
    v_and_b32 v59, 0xffff0000, v119
    v_add_f32_dpp v52, v52, v52 quad_perm:[1,0,3,2] row_mask:0xf bank_mask:0xf
    v_add_f32_dpp v53, v53, v53 quad_perm:[1,0,3,2] row_mask:0xf bank_mask:0xf
    v_add_f32_dpp v54, v54, v54 quad_perm:[1,0,3,2] row_mask:0xf bank_mask:0xf
    v_add_f32_dpp v55, v55, v55 quad_perm:[1,0,3,2] row_mask:0xf bank_mask:0xf
    v_add_f32_dpp v56, v56, v56 quad_perm:[1,0,3,2] row_mask:0xf bank_mask:0xf
    v_add_f32_dpp v57, v57, v57 quad_perm:[1,0,3,2] row_mask:0xf bank_mask:0xf
    v_add_f32_dpp v58, v58, v58 quad_perm:[1,0,3,2] row_mask:0xf bank_mask:0xf
    v_add_f32_dpp v59, v59, v59 quad_perm:[1,0,3,2] row_mask:0xf bank_mask:0xf
    v_add_f32_dpp v52, v52, v52 quad_perm:[2,3,0,1] row_mask:0xf bank_mask:0xf
    v_add_f32_dpp v53, v53, v53 quad_perm:[2,3,0,1] row_mask:0xf bank_mask:0xf
    v_add_f32_dpp v54, v54, v54 quad_perm:[2,3,0,1] row_mask:0xf bank_mask:0xf
    v_add_f32_dpp v55, v55, v55 quad_perm:[2,3,0,1] row_mask:0xf bank_mask:0xf
    v_add_f32_dpp v56, v56, v56 quad_perm:[2,3,0,1] row_mask:0xf bank_mask:0xf
    v_add_f32_dpp v57, v57, v57 quad_perm:[2,3,0,1] row_mask:0xf bank_mask:0xf
    v_add_f32_dpp v58, v58, v58 quad_perm:[2,3,0,1] row_mask:0xf bank_mask:0xf
    v_add_f32_dpp v59, v59, v59 quad_perm:[2,3,0,1] row_mask:0xf bank_mask:0xf
    v_add_f32_dpp v52, v52, v52 row_half_mirror row_mask:0xf bank_mask:0xf
    v_add_f32_dpp v53, v53, v53 row_half_mirror row_mask:0xf bank_mask:0xf
    v_add_f32_dpp v54, v54, v54 row_half_mirror row_mask:0xf bank_mask:0xf
    v_add_f32_dpp v55, v55, v55 row_half_mirror row_mask:0xf bank_mask:0xf
    v_add_f32_dpp v56, v56, v56 row_half_mirror row_mask:0xf bank_mask:0xf
    v_add_f32_dpp v57, v57, v57 row_half_mirror row_mask:0xf bank_mask:0xf
    v_add_f32_dpp v58, v58, v58 row_half_mirror row_mask:0xf bank_mask:0xf
    v_add_f32_dpp v59, v59, v59 row_half_mirror row_mask:0xf bank_mask:0xf
    v_mul_f32 v60, 0xbfb8aa3b, v34
    v_mul_f32 v52, v60, v52
    v_mul_f32 v53, v60, v53
    v_mul_f32 v54, v60, v54
    v_mul_f32 v55, v60, v55
    v_exp_f32 v52, v52
    v_exp_f32 v53, v53
    v_exp_f32 v54, v54
    v_exp_f32 v55, v55
    v_mul_f32 v56, v34, v56
    v_mul_f32 v57, v34, v57
    v_mul_f32 v58, v34, v58
    v_mul_f32 v59, v34, v59
    v_add_f32 v52, 1.0, v52
    v_add_f32 v53, 1.0, v53
    v_add_f32 v54, 1.0, v54
    v_add_f32 v55, 1.0, v55
    v_rcp_f32 v52, v52
    v_rcp_f32 v53, v53
    v_rcp_f32 v54, v54
    v_rcp_f32 v55, v55
    v_mul_f32 v52, v52, v56
    v_mul_f32 v53, v53, v57
    v_mul_f32 v54, v54, v58
    v_mul_f32 v55, v55, v59
    v_cvt_pk_bf16_f32 v52, v52, v53
    v_cvt_pk_bf16_f32 v53, v54, v55
    s_mov_b32 exec_lo, 0x01010101
    s_mov_b32 exec_hi, 0x01010101
    ds_write_b64 v28, v[52:53] offset:6144
    s_mov_b64 exec, -1
L_b7:
    s_waitcnt lgkmcnt(0)
    s_barrier
    s_branch L_OUT
L_fin:
    s_cmp_lg_u32 s3, 0
    s_cbranch_scc1 L_OUT
    s_cmp_ge_u32 s2, 32
    s_cbranch_scc1 L_OUT
    s_lshl_b32 s85, s2, 12
    s_add_u32 s85, s85, 0xf0000
    v_lshlrev_b32 v35, 16, v35
    buffer_load_dwordx4 v[192:195], v4, s[44:47], s85 offen offset:0 sc1
    buffer_load_dwordx4 v[196:199], v4, s[44:47], s85 offen offset:1024 sc1
    buffer_load_dwordx4 v[200:203], v4, s[44:47], s85 offen offset:2048 sc1
    buffer_load_dwordx4 v[204:207], v4, s[44:47], s85 offen offset:3072 sc1
    s_waitcnt vmcnt(0)
    v_cmp_ne_u64 vcc, s[48:49], v[192:193]
    v_cmp_ne_u64 s[50:51], s[48:49], v[196:197]
    s_nop 0
    s_or_b64 vcc, vcc, s[50:51]
    v_cmp_ne_u64 s[50:51], s[48:49], v[200:201]
    s_nop 0
    s_or_b64 vcc, vcc, s[50:51]
    v_cmp_ne_u64 s[50:51], s[48:49], v[204:205]
    s_nop 0
    s_or_b64 vcc, vcc, s[50:51]
    s_cbranch_scc0 L_done_h3_16
L_stub_5:
    s_cbranch_execz L_back
    s_mov_b32 s87, 0
L_retry_h3_15:
    s_add_u32 s87, s87, 1
    s_cmp_gt_u32 s87, 20000
    s_cbranch_scc1 L_END
    buffer_load_dwordx4 v[192:195], v4, s[44:47], s85 offen offset:0 sc1
    buffer_load_dwordx4 v[196:199], v4, s[44:47], s85 offen offset:1024 sc1
    buffer_load_dwordx4 v[200:203], v4, s[44:47], s85 offen offset:2048 sc1
    buffer_load_dwordx4 v[204:207], v4, s[44:47], s85 offen offset:3072 sc1
    s_waitcnt vmcnt(0)
    v_cmp_ne_u64 vcc, s[48:49], v[192:193]
    v_cmp_ne_u64 s[50:51], s[48:49], v[196:197]
    s_nop 0
    s_or_b64 vcc, vcc, s[50:51]
    v_cmp_ne_u64 s[50:51], s[48:49], v[200:201]
    s_nop 0
    s_or_b64 vcc, vcc, s[50:51]
    v_cmp_ne_u64 s[50:51], s[48:49], v[204:205]
    s_nop 0
    s_or_b64 vcc, vcc, s[50:51]
    s_cbranch_scc1 L_retry_h3_15
L_done_h3_16:
    v_lshlrev_b32 v52, 16, v194
    v_and_b32 v53, 0xffff0000, v194
    v_lshlrev_b32 v54, 16, v195
    v_and_b32 v55, 0xffff0000, v195
    v_lshlrev_b32 v56, 16, v198
    v_and_b32 v57, 0xffff0000, v198
    v_lshlrev_b32 v58, 16, v199
    v_and_b32 v59, 0xffff0000, v199
    v_lshlrev_b32 v60, 16, v202
    v_and_b32 v61, 0xffff0000, v202
    v_lshlrev_b32 v62, 16, v203
    v_and_b32 v63, 0xffff0000, v203
    v_lshlrev_b32 v64, 16, v206
    v_and_b32 v65, 0xffff0000, v206
    v_lshlrev_b32 v66, 16, v207
    v_and_b32 v67, 0xffff0000, v207
    v_add_f32 v52, v52, v56
    v_add_f32 v60, v60, v64
    v_add_f32 v53, v53, v57
    v_add_f32 v61, v61, v65
    v_add_f32 v54, v54, v58
    v_add_f32 v62, v62, v66
    v_add_f32 v55, v55, v59
    v_add_f32 v63, v63, v67
    v_add_f32 v52, v52, v60
    v_add_f32 v53, v53, v61
    v_add_f32 v54, v54, v62
    v_add_f32 v55, v55, v63
    v_permlane16_swap_b32 v52, v53
    s_nop 0
    v_permlane16_swap_b32 v54, v55
    v_add_f32 v52, v52, v53
    v_add_f32 v54, v54, v55
    s_nop 1
    v_permlane32_swap_b32 v52, v54
    v_add_f32 v52, v52, v54
    s_nop 1
    v_add_f32_dpp v52, v52, v52 row_ror:8 row_mask:0xf bank_mask:0xf
    v_add_f32 v52, v52, v35
    v_cvt_pk_bf16_f32 v52, v52, v52
    s_mov_b64 exec, s[54:55]
    buffer_store_short v52, v28, s[40:43], 0 offen
    s_cmp_lg_u32 s2, 0
    s_cbranch_scc1 L_OUT
    s_mov_b64 exec, 1
    buffer_store_dword v48, v4, s[44:47], 0 offen sc1
L_OUT:
L_END:
    s_endpgm
L_CODE_END:
.section .rodata,"a"
.p2align 6
.amdhsa_kernel parallel_sum__compressed_kv_cla__glu_gated_glu__decode_kernel
  .amdhsa_next_free_vgpr 256
  .amdhsa_next_free_sgpr 102
  .amdhsa_accum_offset 256
  .amdhsa_group_segment_fixed_size 0
  .amdhsa_kernarg_size 104
  .amdhsa_user_sgpr_count 2
  .amdhsa_user_sgpr_kernarg_segment_ptr 1
  .amdhsa_system_sgpr_workgroup_id_x 1
  .amdhsa_float_denorm_mode_32 3
.end_amdhsa_kernel
```
